```python
import torch

def _softmax(x, axis=-1):
    return torch.softmax(x, dim=axis)
def _gelu(x):
    return torch.nn.functional.gelu(x, approximate="tanh")
def _silu(x):
    return torch.nn.functional.silu(x)
def _sigmoid(x):
    return torch.sigmoid(x)
def _layernorm(x, axis=-1, eps=1e-5):
    m = x.mean(dim=axis, keepdim=True)
    v = x.var(dim=axis, keepdim=True, unbiased=False)
    return (x - m) / torch.sqrt(v + eps)
def _scatter_add(tgt, idx, src, axis=0):
    return tgt.clone().index_add_(axis, idx, src)
def _segment_sum(src, seg, n):
    out = torch.zeros((n,) + src.shape[1:], dtype=src.dtype)
    return out.index_add_(0, seg, src)
def _pad(x, pw):
    flat = tuple(v for pair in reversed(pw) for v in pair)
    return torch.nn.functional.pad(x, flat)

kernel_name = 'concat_heads__sliding_block_cached__sliding_block_cached__decode'

def setup_inputs():

    _w = (lambda a: (lambda t: t.to(torch.bfloat16) if t.is_floating_point() else t)(torch.as_tensor(a)))
    def _A_setup():
        B, Sq, D = 4, 1, 512
        Hq, Hkv, Sk, Dh = 32, 8, 8192, 128
        assert Hq % Hkv == 0, (Hq, Hkv)
        return {
            "x": _w((lambda *s: torch.randn(*s, dtype=torch.bfloat16) * 0.8)(B, Sq, D)),
            "k_cache": _w((lambda *s: torch.randn(*s, dtype=torch.bfloat16) * 1.6)(B, Hkv, Sk, Dh)),
            "v_cache": _w((lambda *s: torch.randn(*s, dtype=torch.bfloat16) * 0.2)(B, Hkv, Sk, Dh)),
            "wq": _w((lambda *s: torch.randn(*s, dtype=torch.bfloat16) * 1.6)(D, Hq * Dh) * (D ** -0.5)),
            "wo": _w((lambda *s: torch.randn(*s, dtype=torch.bfloat16) * 0.2)(Hq * Dh, D) * ((Hq * Dh) ** -0.5)),
        }
    _A_in = _A_setup()

    def _B_setup():
        B, Sq, D = 4, 1, 512
        Hq, Hkv, Sk, Dh = 32, 8, 8192, 128
        assert Hq % Hkv == 0, (Hq, Hkv)
        return {
            "x": _w((lambda *s: torch.randn(*s, dtype=torch.bfloat16) * 0.8)(B, Sq, D)),
            "k_cache": _w((lambda *s: torch.randn(*s, dtype=torch.bfloat16) * 1.6)(B, Hkv, Sk, Dh)),
            "v_cache": _w((lambda *s: torch.randn(*s, dtype=torch.bfloat16) * 0.2)(B, Hkv, Sk, Dh)),
            "wq": _w((lambda *s: torch.randn(*s, dtype=torch.bfloat16) * 1.6)(D, Hq * Dh) * (D ** -0.5)),
            "wo": _w((lambda *s: torch.randn(*s, dtype=torch.bfloat16) * 0.2)(Hq * Dh, D) * ((Hq * Dh) ** -0.5)),
        }
    _B_in = _B_setup()

    return {
        "A_x": _A_in["x"],
        "A_k_cache": _A_in["k_cache"],
        "A_v_cache": _A_in["v_cache"],
        "A_wq": _A_in["wq"],
        "A_wo": _A_in["wo"],
        "B_x": _B_in["x"],
        "B_k_cache": _B_in["k_cache"],
        "B_v_cache": _B_in["v_cache"],
        "B_wq": _B_in["wq"],
        "B_wo": _B_in["wo"],
    }

def reference(A_x, A_k_cache, A_v_cache, A_wq, A_wo, B_x, B_k_cache, B_v_cache, B_wq, B_wo):
    def _A_ref(x, k_cache, v_cache, wq, wo):
        B, Sq, D = x.shape
        Hq, Dh = 32, 128
        Hkv, Sk = k_cache.shape[1], k_cache.shape[2]
        W = min(4096, max(256, Sk // 4))
        rep = Hq // Hkv
        q = (lambda x, *d: x.permute(*d))((x @ wq).reshape(B, Sq, Hq, Dh), 0, 2, 1, 3)
        k = (lambda x, n, axis: torch.repeat_interleave(x, n, dim=axis))(k_cache[:, :, Sk - W:, :], rep, axis=1)
        v = (lambda x, n, axis: torch.repeat_interleave(x, n, dim=axis))(v_cache[:, :, Sk - W:, :], rep, axis=1)
        scores = torch.einsum("bhqd,bhkd->bhqk", q, k) * (Dh ** -0.5)
        p = _softmax(scores, axis=-1)
        o = torch.einsum("bhqk,bhkd->bhqd", p, v)
        return (lambda x, *d: x.permute(*d))(o, 0, 2, 1, 3).reshape(B, Sq, Hq * Dh) @ wo

    def _B_ref(x, k_cache, v_cache, wq, wo):
        B, Sq, D = x.shape
        Hq, Dh = 32, 128
        Hkv, Sk = k_cache.shape[1], k_cache.shape[2]
        W = min(4096, max(256, Sk // 4))
        rep = Hq // Hkv
        q = (lambda x, *d: x.permute(*d))((x @ wq).reshape(B, Sq, Hq, Dh), 0, 2, 1, 3)
        k = (lambda x, n, axis: torch.repeat_interleave(x, n, dim=axis))(k_cache[:, :, Sk - W:, :], rep, axis=1)
        v = (lambda x, n, axis: torch.repeat_interleave(x, n, dim=axis))(v_cache[:, :, Sk - W:, :], rep, axis=1)
        scores = torch.einsum("bhqd,bhkd->bhqk", q, k) * (Dh ** -0.5)
        p = _softmax(scores, axis=-1)
        o = torch.einsum("bhqk,bhkd->bhqd", p, v)
        return (lambda x, *d: x.permute(*d))(o, 0, 2, 1, 3).reshape(B, Sq, Hq * Dh) @ wo

    a = _A_ref(A_x, A_k_cache, A_v_cache, A_wq, A_wo)
    b = _B_ref(B_x, B_k_cache, B_v_cache, B_wq, B_wo)
    return torch.concatenate([a, b], axis=-1)
```

```asm
; @launch kernel=qproj_kernel grid=(64,1,1) block=(1024,1,1) lds=32768
; @launch kernel=concat_heads__sliding_block_cached__sliding_block_cached__decode_kernel grid=(256,1,1) block=(512,1,1) lds=16640
; @launch kernel=oproj_kernel grid=(256,1,1) block=(256,1,1) lds=8256
.amdgcn_target "amdgcn-amd-amdhsa--gfx950"
.text
.globl qproj_kernel
.p2align 8
.type qproj_kernel,@function
qproj_kernel:
    s_cmp_ge_u32 s2, 64
    s_cbranch_scc1 L_q_done
    s_lshr_b32 s3, s2, 5
    s_mul_i32 s4, s3, 40
    s_load_dwordx2 s[8:9], s[0:1], s4
    s_add_u32 s5, s4, 24
    s_load_dwordx2 s[12:13], s[0:1], s5
    s_load_dwordx2 s[16:17], s[0:1], 96
    s_and_b32 s6, s2, 31
    v_and_b32 v1, 63, v0
    v_lshrrev_b32 v2, 6, v0
    v_and_b32 v3, 3, v1
    v_lshlrev_b32 v3, 10, v3
    v_lshrrev_b32 v4, 4, v1
    v_lshlrev_b32 v5, 4, v4
    v_add_u32 v3, v3, v5
    v_lshlrev_b32 v5, 6, v2
    v_add_u32 v3, v3, v5
    v_lshlrev_b32 v5, 18, v2
    v_lshlrev_b32 v6, 16, v4
    v_add_u32 v5, v5, v6
    v_and_b32 v6, 15, v1
    v_lshlrev_b32 v6, 4, v6
    v_add_u32 v5, v5, v6
    s_lshl_b32 s7, s6, 8
    v_add_u32 v5, s7, v5
    s_mov_b32 s20, 0x0
    s_mov_b32 s21, 0x2000
    s_mov_b32 s22, 0x4000
    s_mov_b32 s23, 0x6000
    s_mov_b32 s24, 0x8000
    s_mov_b32 s25, 0xa000
    s_mov_b32 s26, 0xc000
    s_mov_b32 s27, 0xe000
    s_mov_b32 s28, 0x05040100
    s_mov_b32 s29, 0x07060302
    s_waitcnt lgkmcnt(0)
    s_mov_b32 s10, 0x1000
    s_mov_b32 s11, 0x00020000
    s_mov_b32 s14, 0x400000
    s_mov_b32 s15, 0x00020000
    s_mov_b32 s18, 0x11002000
    s_mov_b32 s19, 0x00020000
    buffer_load_dwordx4 v[8:11], v3, s[8:11], 0 offen
    buffer_load_dwordx4 v[12:15], v5, s[12:15], s20 offen nt
    buffer_load_dwordx4 v[16:19], v5, s[12:15], s21 offen nt
    buffer_load_dwordx4 v[20:23], v5, s[12:15], s22 offen nt
    buffer_load_dwordx4 v[24:27], v5, s[12:15], s23 offen nt
    buffer_load_dwordx4 v[28:31], v5, s[12:15], s24 offen nt
    buffer_load_dwordx4 v[32:35], v5, s[12:15], s25 offen nt
    buffer_load_dwordx4 v[36:39], v5, s[12:15], s26 offen nt
    buffer_load_dwordx4 v[40:43], v5, s[12:15], s27 offen nt
    s_waitcnt vmcnt(0)
    v_perm_b32 v44, v16, v12, s28
    v_perm_b32 v45, v24, v20, s28
    v_perm_b32 v46, v32, v28, s28
    v_perm_b32 v47, v40, v36, s28
    s_nop 1
    v_mfma_f32_16x16x32_bf16 v[52:55], v[8:11], v[44:47], 0
    v_perm_b32 v48, v16, v12, s29
    v_perm_b32 v49, v24, v20, s29
    v_perm_b32 v50, v32, v28, s29
    v_perm_b32 v51, v40, v36, s29
    s_nop 1
    v_mfma_f32_16x16x32_bf16 v[56:59], v[8:11], v[48:51], 0
    v_perm_b32 v44, v17, v13, s28
    v_perm_b32 v45, v25, v21, s28
    v_perm_b32 v46, v33, v29, s28
    v_perm_b32 v47, v41, v37, s28
    s_nop 1
    v_mfma_f32_16x16x32_bf16 v[60:63], v[8:11], v[44:47], 0
    v_perm_b32 v48, v17, v13, s29
    v_perm_b32 v49, v25, v21, s29
    v_perm_b32 v50, v33, v29, s29
    v_perm_b32 v51, v41, v37, s29
    s_nop 1
    v_mfma_f32_16x16x32_bf16 v[64:67], v[8:11], v[48:51], 0
    v_perm_b32 v44, v18, v14, s28
    v_perm_b32 v45, v26, v22, s28
    v_perm_b32 v46, v34, v30, s28
    v_perm_b32 v47, v42, v38, s28
    s_nop 1
    v_mfma_f32_16x16x32_bf16 v[68:71], v[8:11], v[44:47], 0
    v_perm_b32 v48, v18, v14, s29
    v_perm_b32 v49, v26, v22, s29
    v_perm_b32 v50, v34, v30, s29
    v_perm_b32 v51, v42, v38, s29
    s_nop 1
    v_mfma_f32_16x16x32_bf16 v[72:75], v[8:11], v[48:51], 0
    v_perm_b32 v44, v19, v15, s28
    v_perm_b32 v45, v27, v23, s28
    v_perm_b32 v46, v35, v31, s28
    v_perm_b32 v47, v43, v39, s28
    s_nop 1
    v_mfma_f32_16x16x32_bf16 v[76:79], v[8:11], v[44:47], 0
    v_perm_b32 v48, v19, v15, s29
    v_perm_b32 v49, v27, v23, s29
    v_perm_b32 v50, v35, v31, s29
    v_perm_b32 v51, v43, v39, s29
    s_nop 1
    v_mfma_f32_16x16x32_bf16 v[80:83], v[8:11], v[48:51], 0
    s_nop 7
    s_nop 3
    v_lshlrev_b32 v6, 11, v2
    v_and_b32 v7, 15, v1
    v_lshlrev_b32 v7, 5, v7
    v_add_u32 v6, v6, v7
    v_cmp_gt_u32 vcc, 16, v1
    s_and_saveexec_b64 s[30:31], vcc
    ds_write_b32 v6, v52 offset:0
    ds_write_b32 v6, v53 offset:512
    ds_write_b32 v6, v54 offset:1024
    ds_write_b32 v6, v55 offset:1536
    ds_write_b32 v6, v56 offset:4
    ds_write_b32 v6, v57 offset:516
    ds_write_b32 v6, v58 offset:1028
    ds_write_b32 v6, v59 offset:1540
    ds_write_b32 v6, v60 offset:8
    ds_write_b32 v6, v61 offset:520
    ds_write_b32 v6, v62 offset:1032
    ds_write_b32 v6, v63 offset:1544
    ds_write_b32 v6, v64 offset:12
    ds_write_b32 v6, v65 offset:524
    ds_write_b32 v6, v66 offset:1036
    ds_write_b32 v6, v67 offset:1548
    ds_write_b32 v6, v68 offset:16
    ds_write_b32 v6, v69 offset:528
    ds_write_b32 v6, v70 offset:1040
    ds_write_b32 v6, v71 offset:1552
    ds_write_b32 v6, v72 offset:20
    ds_write_b32 v6, v73 offset:532
    ds_write_b32 v6, v74 offset:1044
    ds_write_b32 v6, v75 offset:1556
    ds_write_b32 v6, v76 offset:24
    ds_write_b32 v6, v77 offset:536
    ds_write_b32 v6, v78 offset:1048
    ds_write_b32 v6, v79 offset:1560
    ds_write_b32 v6, v80 offset:28
    ds_write_b32 v6, v81 offset:540
    ds_write_b32 v6, v82 offset:1052
    ds_write_b32 v6, v83 offset:1564
    s_mov_b64 exec, s[30:31]
    s_waitcnt lgkmcnt(0)
    s_barrier
    v_cmp_gt_u32 vcc, 512, v0
    s_and_saveexec_b64 s[30:31], vcc
    s_cbranch_execz L_q_restore
    v_lshlrev_b32 v6, 2, v0
    ds_read_b32 v12, v6 offset:0
    ds_read_b32 v13, v6 offset:2048
    ds_read_b32 v14, v6 offset:4096
    ds_read_b32 v15, v6 offset:6144
    ds_read_b32 v16, v6 offset:8192
    ds_read_b32 v17, v6 offset:10240
    ds_read_b32 v18, v6 offset:12288
    ds_read_b32 v19, v6 offset:14336
    ds_read_b32 v20, v6 offset:16384
    ds_read_b32 v21, v6 offset:18432
    ds_read_b32 v22, v6 offset:20480
    ds_read_b32 v23, v6 offset:22528
    ds_read_b32 v24, v6 offset:24576
    ds_read_b32 v25, v6 offset:26624
    ds_read_b32 v26, v6 offset:28672
    ds_read_b32 v27, v6 offset:30720
    s_waitcnt lgkmcnt(0)
    v_add_f32 v12, v12, v13
    v_add_f32 v12, v12, v14
    v_add_f32 v12, v12, v15
    v_add_f32 v12, v12, v16
    v_add_f32 v12, v12, v17
    v_add_f32 v12, v12, v18
    v_add_f32 v12, v12, v19
    v_add_f32 v12, v12, v20
    v_add_f32 v12, v12, v21
    v_add_f32 v12, v12, v22
    v_add_f32 v12, v12, v23
    v_add_f32 v12, v12, v24
    v_add_f32 v12, v12, v25
    v_add_f32 v12, v12, v26
    v_add_f32 v12, v12, v27
    v_cvt_pk_bf16_f32 v12, v12, v12
    v_lshrrev_b32 v7, 7, v0
    v_lshlrev_b32 v7, 13, v7
    v_and_b32 v8, 127, v0
    v_lshlrev_b32 v8, 1, v8
    v_add_u32 v7, v7, v8
    s_lshl_b32 s7, s3, 15
    s_lshl_b32 s5, s6, 8
    s_add_u32 s7, s7, s5
    v_add_u32 v7, s7, v7
    buffer_store_short v12, v7, s[16:19], 0 offen
    s_waitcnt vmcnt(0)
L_q_restore:
    s_mov_b64 exec, s[30:31]
L_q_done:
    s_endpgm
.globl concat_heads__sliding_block_cached__sliding_block_cached__decode_kernel
.p2align 8
.type concat_heads__sliding_block_cached__sliding_block_cached__decode_kernel,@function
concat_heads__sliding_block_cached__sliding_block_cached__decode_kernel:
    s_cmp_ge_u32 s2, 256
    s_cbranch_scc1 L_a_done
    s_lshr_b32 s3, s2, 7
    s_mul_i32 s4, s3, 40
    s_add_u32 s5, s4, 8
    s_load_dwordx2 s[8:9], s[0:1], s5
    s_add_u32 s5, s4, 16
    s_load_dwordx2 s[12:13], s[0:1], s5
    s_load_dwordx2 s[16:17], s[0:1], 96
    s_lshr_b32 s4, s2, 5
    s_and_b32 s4, s4, 3
    s_lshr_b32 s5, s2, 2
    s_and_b32 s5, s5, 7
    s_and_b32 s6, s2, 3
    v_and_b32 v1, 63, v0
    v_lshrrev_b32 v2, 6, v0
    v_and_b32 v3, 15, v1
    v_lshrrev_b32 v4, 4, v1
    v_lshlrev_b32 v5, 8, v3
    v_lshlrev_b32 v6, 4, v4
    v_add_u32 v5, v5, v6
    v_lshlrev_b32 v6, 14, v2
    v_add_u32 v5, v5, v6
    v_lshlrev_b32 v7, 10, v4
    v_lshlrev_b32 v8, 4, v3
    v_add_u32 v7, v7, v8
    v_add_u32 v7, v7, v6
    v_and_b32 v8, 3, v1
    v_lshlrev_b32 v8, 8, v8
    v_lshlrev_b32 v9, 4, v4
    v_add_u32 v8, v8, v9
    s_lshl_b32 s7, s3, 15
    s_lshl_b32 s20, s4, 13
    s_add_u32 s7, s7, s20
    s_lshl_b32 s20, s5, 10
    s_add_u32 s7, s7, s20
    v_add_u32 v8, s7, v8
    s_lshl_b32 s20, s4, 3
    s_add_u32 s20, s20, s5
    s_lshl_b32 s20, s20, 21
    s_lshl_b32 s21, s6, 17
    s_add_u32 s20, s20, s21
    s_add_u32 s20, s20, 0x180000
    s_add_u32 s21, s20, 0x1000
    s_add_u32 s22, s20, 0x2000
    s_add_u32 s23, s20, 0x3000
    s_mov_b32 s28, 0x05040100
    s_mov_b32 s29, 0x07060302
    s_waitcnt lgkmcnt(0)
    s_mov_b32 s10, 0x4000000
    s_mov_b32 s11, 0x00020000
    s_mov_b32 s14, 0x4000000
    s_mov_b32 s15, 0x00020000
    s_mov_b32 s18, 0x11002000
    s_mov_b32 s19, 0x00020000
    buffer_load_dwordx4 v[16:19], v8, s[16:19], 0 offen offset:0
    buffer_load_dwordx4 v[20:23], v8, s[16:19], 0 offen offset:64
    buffer_load_dwordx4 v[24:27], v8, s[16:19], 0 offen offset:128
    buffer_load_dwordx4 v[28:31], v8, s[16:19], 0 offen offset:192
    buffer_load_dwordx4 v[32:35], v5, s[8:11], s20 offen offset:0 nt
    buffer_load_dwordx4 v[36:39], v5, s[8:11], s20 offen offset:64 nt
    buffer_load_dwordx4 v[40:43], v5, s[8:11], s20 offen offset:128 nt
    buffer_load_dwordx4 v[44:47], v5, s[8:11], s20 offen offset:192 nt
    buffer_load_dwordx4 v[48:51], v5, s[8:11], s21 offen offset:0 nt
    buffer_load_dwordx4 v[52:55], v5, s[8:11], s21 offen offset:64 nt
    buffer_load_dwordx4 v[56:59], v5, s[8:11], s21 offen offset:128 nt
    buffer_load_dwordx4 v[60:63], v5, s[8:11], s21 offen offset:192 nt
    buffer_load_dwordx4 v[64:67], v5, s[8:11], s22 offen offset:0 nt
    buffer_load_dwordx4 v[68:71], v5, s[8:11], s22 offen offset:64 nt
    buffer_load_dwordx4 v[72:75], v5, s[8:11], s22 offen offset:128 nt
    buffer_load_dwordx4 v[76:79], v5, s[8:11], s22 offen offset:192 nt
    buffer_load_dwordx4 v[80:83], v5, s[8:11], s23 offen offset:0 nt
    buffer_load_dwordx4 v[84:87], v5, s[8:11], s23 offen offset:64 nt
    buffer_load_dwordx4 v[88:91], v5, s[8:11], s23 offen offset:128 nt
    buffer_load_dwordx4 v[92:95], v5, s[8:11], s23 offen offset:192 nt
    buffer_load_dwordx4 v[96:99], v7, s[12:15], s20 offen offset:0 nt
    buffer_load_dwordx4 v[100:103], v7, s[12:15], s20 offen offset:256 nt
    buffer_load_dwordx4 v[104:107], v7, s[12:15], s20 offen offset:512 nt
    buffer_load_dwordx4 v[108:111], v7, s[12:15], s20 offen offset:768 nt
    buffer_load_dwordx4 v[112:115], v7, s[12:15], s21 offen offset:0 nt
    buffer_load_dwordx4 v[116:119], v7, s[12:15], s21 offen offset:256 nt
    buffer_load_dwordx4 v[120:123], v7, s[12:15], s21 offen offset:512 nt
    buffer_load_dwordx4 v[124:127], v7, s[12:15], s21 offen offset:768 nt
    buffer_load_dwordx4 v[128:131], v7, s[12:15], s22 offen offset:0 nt
    buffer_load_dwordx4 v[132:135], v7, s[12:15], s22 offen offset:256 nt
    buffer_load_dwordx4 v[136:139], v7, s[12:15], s22 offen offset:512 nt
    buffer_load_dwordx4 v[140:143], v7, s[12:15], s22 offen offset:768 nt
    buffer_load_dwordx4 v[144:147], v7, s[12:15], s23 offen offset:0 nt
    buffer_load_dwordx4 v[148:151], v7, s[12:15], s23 offen offset:256 nt
    buffer_load_dwordx4 v[152:155], v7, s[12:15], s23 offen offset:512 nt
    buffer_load_dwordx4 v[156:159], v7, s[12:15], s23 offen offset:768 nt
    s_waitcnt vmcnt(28)
    v_mfma_f32_16x16x32_bf16 v[160:163], v[32:35], v[16:19], 0
    v_mfma_f32_16x16x32_bf16 v[160:163], v[36:39], v[20:23], v[160:163]
    v_mfma_f32_16x16x32_bf16 v[160:163], v[40:43], v[24:27], v[160:163]
    v_mfma_f32_16x16x32_bf16 v[160:163], v[44:47], v[28:31], v[160:163]
    s_waitcnt vmcnt(24)
    v_mfma_f32_16x16x32_bf16 v[164:167], v[48:51], v[16:19], 0
    v_mfma_f32_16x16x32_bf16 v[164:167], v[52:55], v[20:23], v[164:167]
    v_mfma_f32_16x16x32_bf16 v[164:167], v[56:59], v[24:27], v[164:167]
    v_mfma_f32_16x16x32_bf16 v[164:167], v[60:63], v[28:31], v[164:167]
    s_waitcnt vmcnt(20)
    v_mfma_f32_16x16x32_bf16 v[168:171], v[64:67], v[16:19], 0
    v_mfma_f32_16x16x32_bf16 v[168:171], v[68:71], v[20:23], v[168:171]
    v_mfma_f32_16x16x32_bf16 v[168:171], v[72:75], v[24:27], v[168:171]
    v_mfma_f32_16x16x32_bf16 v[168:171], v[76:79], v[28:31], v[168:171]
    s_waitcnt vmcnt(16)
    v_mfma_f32_16x16x32_bf16 v[172:175], v[80:83], v[16:19], 0
    v_mfma_f32_16x16x32_bf16 v[172:175], v[84:87], v[20:23], v[172:175]
    v_mfma_f32_16x16x32_bf16 v[172:175], v[88:91], v[24:27], v[172:175]
    v_mfma_f32_16x16x32_bf16 v[172:175], v[92:95], v[28:31], v[172:175]
    s_nop 7
    s_nop 3
    v_max3_f32 v10, v160, v161, v162
    v_max3_f32 v10, v10, v163, v164
    v_max3_f32 v10, v10, v165, v166
    v_max3_f32 v10, v10, v167, v168
    v_max3_f32 v10, v10, v169, v170
    v_max3_f32 v10, v10, v171, v172
    v_max3_f32 v10, v10, v173, v174
    v_max_f32 v10, v10, v175
    v_lshlrev_b32 v11, 2, v1
    v_xor_b32 v12, 64, v11
    ds_bpermute_b32 v13, v12, v10
    s_waitcnt lgkmcnt(0)
    v_max_f32 v10, v10, v13
    v_xor_b32 v14, 0x80, v11
    ds_bpermute_b32 v13, v14, v10
    s_waitcnt lgkmcnt(0)
    v_max_f32 v10, v10, v13
    s_mov_b32 s24, 0x3e0293ee
    v_mul_f32 v15, s24, v10
    v_sub_f32 v15, 0, v15
    v_fma_f32 v160, v160, s24, v15
    v_fma_f32 v161, v161, s24, v15
    v_fma_f32 v162, v162, s24, v15
    v_fma_f32 v163, v163, s24, v15
    v_fma_f32 v164, v164, s24, v15
    v_fma_f32 v165, v165, s24, v15
    v_fma_f32 v166, v166, s24, v15
    v_fma_f32 v167, v167, s24, v15
    v_fma_f32 v168, v168, s24, v15
    v_fma_f32 v169, v169, s24, v15
    v_fma_f32 v170, v170, s24, v15
    v_fma_f32 v171, v171, s24, v15
    v_fma_f32 v172, v172, s24, v15
    v_fma_f32 v173, v173, s24, v15
    v_fma_f32 v174, v174, s24, v15
    v_fma_f32 v175, v175, s24, v15
    v_exp_f32 v160, v160
    v_exp_f32 v161, v161
    v_exp_f32 v162, v162
    v_exp_f32 v163, v163
    v_exp_f32 v164, v164
    v_exp_f32 v165, v165
    v_exp_f32 v166, v166
    v_exp_f32 v167, v167
    v_exp_f32 v168, v168
    v_exp_f32 v169, v169
    v_exp_f32 v170, v170
    v_exp_f32 v171, v171
    v_exp_f32 v172, v172
    v_exp_f32 v173, v173
    v_exp_f32 v174, v174
    v_exp_f32 v175, v175
    s_nop 1
    v_add_f32 v13, v160, v161
    v_add_f32 v13, v13, v162
    v_add_f32 v13, v13, v163
    v_add_f32 v13, v13, v164
    v_add_f32 v13, v13, v165
    v_add_f32 v13, v13, v166
    v_add_f32 v13, v13, v167
    v_add_f32 v13, v13, v168
    v_add_f32 v13, v13, v169
    v_add_f32 v13, v13, v170
    v_add_f32 v13, v13, v171
    v_add_f32 v13, v13, v172
    v_add_f32 v13, v13, v173
    v_add_f32 v13, v13, v174
    v_add_f32 v13, v13, v175
    v_cvt_pk_bf16_f32 v176, v160, v161
    v_cvt_pk_bf16_f32 v177, v162, v163
    v_cvt_pk_bf16_f32 v178, v164, v165
    v_cvt_pk_bf16_f32 v179, v166, v167
    v_cvt_pk_bf16_f32 v180, v168, v169
    v_cvt_pk_bf16_f32 v181, v170, v171
    v_cvt_pk_bf16_f32 v182, v172, v173
    v_cvt_pk_bf16_f32 v183, v174, v175
    ds_bpermute_b32 v224, v12, v13
    s_waitcnt lgkmcnt(0)
    v_add_f32 v13, v13, v224
    ds_bpermute_b32 v224, v14, v13
    s_waitcnt lgkmcnt(0)
    v_add_f32 v13, v13, v224
    s_waitcnt vmcnt(8)
    v_perm_b32 v216, v100, v96, s28
    v_perm_b32 v217, v108, v104, s28
    v_perm_b32 v218, v116, v112, s28
    v_perm_b32 v219, v124, v120, s28
    s_nop 1
    v_mfma_f32_16x16x32_bf16 v[184:187], v[216:219], v[176:179], 0
    v_perm_b32 v220, v100, v96, s29
    v_perm_b32 v221, v108, v104, s29
    v_perm_b32 v222, v116, v112, s29
    v_perm_b32 v223, v124, v120, s29
    s_nop 1
    v_mfma_f32_16x16x32_bf16 v[188:191], v[220:223], v[176:179], 0
    v_perm_b32 v216, v101, v97, s28
    v_perm_b32 v217, v109, v105, s28
    v_perm_b32 v218, v117, v113, s28
    v_perm_b32 v219, v125, v121, s28
    s_nop 1
    v_mfma_f32_16x16x32_bf16 v[192:195], v[216:219], v[176:179], 0
    v_perm_b32 v220, v101, v97, s29
    v_perm_b32 v221, v109, v105, s29
    v_perm_b32 v222, v117, v113, s29
    v_perm_b32 v223, v125, v121, s29
    s_nop 1
    v_mfma_f32_16x16x32_bf16 v[196:199], v[220:223], v[176:179], 0
    v_perm_b32 v216, v102, v98, s28
    v_perm_b32 v217, v110, v106, s28
    v_perm_b32 v218, v118, v114, s28
    v_perm_b32 v219, v126, v122, s28
    s_nop 1
    v_mfma_f32_16x16x32_bf16 v[200:203], v[216:219], v[176:179], 0
    v_perm_b32 v220, v102, v98, s29
    v_perm_b32 v221, v110, v106, s29
    v_perm_b32 v222, v118, v114, s29
    v_perm_b32 v223, v126, v122, s29
    s_nop 1
    v_mfma_f32_16x16x32_bf16 v[204:207], v[220:223], v[176:179], 0
    v_perm_b32 v216, v103, v99, s28
    v_perm_b32 v217, v111, v107, s28
    v_perm_b32 v218, v119, v115, s28
    v_perm_b32 v219, v127, v123, s28
    s_nop 1
    v_mfma_f32_16x16x32_bf16 v[208:211], v[216:219], v[176:179], 0
    v_perm_b32 v220, v103, v99, s29
    v_perm_b32 v221, v111, v107, s29
    v_perm_b32 v222, v119, v115, s29
    v_perm_b32 v223, v127, v123, s29
    s_nop 1
    v_mfma_f32_16x16x32_bf16 v[212:215], v[220:223], v[176:179], 0
    s_waitcnt vmcnt(0)
    v_perm_b32 v216, v132, v128, s28
    v_perm_b32 v217, v140, v136, s28
    v_perm_b32 v218, v148, v144, s28
    v_perm_b32 v219, v156, v152, s28
    s_nop 1
    v_mfma_f32_16x16x32_bf16 v[184:187], v[216:219], v[180:183], v[184:187]
    v_perm_b32 v220, v132, v128, s29
    v_perm_b32 v221, v140, v136, s29
    v_perm_b32 v222, v148, v144, s29
    v_perm_b32 v223, v156, v152, s29
    s_nop 1
    v_mfma_f32_16x16x32_bf16 v[188:191], v[220:223], v[180:183], v[188:191]
    v_perm_b32 v216, v133, v129, s28
    v_perm_b32 v217, v141, v137, s28
    v_perm_b32 v218, v149, v145, s28
    v_perm_b32 v219, v157, v153, s28
    s_nop 1
    v_mfma_f32_16x16x32_bf16 v[192:195], v[216:219], v[180:183], v[192:195]
    v_perm_b32 v220, v133, v129, s29
    v_perm_b32 v221, v141, v137, s29
    v_perm_b32 v222, v149, v145, s29
    v_perm_b32 v223, v157, v153, s29
    s_nop 1
    v_mfma_f32_16x16x32_bf16 v[196:199], v[220:223], v[180:183], v[196:199]
    v_perm_b32 v216, v134, v130, s28
    v_perm_b32 v217, v142, v138, s28
    v_perm_b32 v218, v150, v146, s28
    v_perm_b32 v219, v158, v154, s28
    s_nop 1
    v_mfma_f32_16x16x32_bf16 v[200:203], v[216:219], v[180:183], v[200:203]
    v_perm_b32 v220, v134, v130, s29
    v_perm_b32 v221, v142, v138, s29
    v_perm_b32 v222, v150, v146, s29
    v_perm_b32 v223, v158, v154, s29
    s_nop 1
    v_mfma_f32_16x16x32_bf16 v[204:207], v[220:223], v[180:183], v[204:207]
    v_perm_b32 v216, v135, v131, s28
    v_perm_b32 v217, v143, v139, s28
    v_perm_b32 v218, v151, v147, s28
    v_perm_b32 v219, v159, v155, s28
    s_nop 1
    v_mfma_f32_16x16x32_bf16 v[208:211], v[216:219], v[180:183], v[208:211]
    v_perm_b32 v220, v135, v131, s29
    v_perm_b32 v221, v143, v139, s29
    v_perm_b32 v222, v151, v147, s29
    v_perm_b32 v223, v159, v155, s29
    s_nop 1
    v_mfma_f32_16x16x32_bf16 v[212:215], v[220:223], v[180:183], v[212:215]
    s_nop 7
    s_nop 3
    v_lshlrev_b32 v224, 11, v2
    v_lshlrev_b32 v225, 9, v3
    v_add_u32 v224, v224, v225
    v_lshlrev_b32 v225, 7, v4
    v_add_u32 v224, v224, v225
    v_cmp_gt_u32 vcc, 4, v3
    s_and_saveexec_b64 s[30:31], vcc
    ds_write_b32 v224, v184 offset:0
    ds_write_b32 v224, v185 offset:32
    ds_write_b32 v224, v186 offset:64
    ds_write_b32 v224, v187 offset:96
    ds_write_b32 v224, v188 offset:4
    ds_write_b32 v224, v189 offset:36
    ds_write_b32 v224, v190 offset:68
    ds_write_b32 v224, v191 offset:100
    ds_write_b32 v224, v192 offset:8
    ds_write_b32 v224, v193 offset:40
    ds_write_b32 v224, v194 offset:72
    ds_write_b32 v224, v195 offset:104
    ds_write_b32 v224, v196 offset:12
    ds_write_b32 v224, v197 offset:44
    ds_write_b32 v224, v198 offset:76
    ds_write_b32 v224, v199 offset:108
    ds_write_b32 v224, v200 offset:16
    ds_write_b32 v224, v201 offset:48
    ds_write_b32 v224, v202 offset:80
    ds_write_b32 v224, v203 offset:112
    ds_write_b32 v224, v204 offset:20
    ds_write_b32 v224, v205 offset:52
    ds_write_b32 v224, v206 offset:84
    ds_write_b32 v224, v207 offset:116
    ds_write_b32 v224, v208 offset:24
    ds_write_b32 v224, v209 offset:56
    ds_write_b32 v224, v210 offset:88
    ds_write_b32 v224, v211 offset:120
    ds_write_b32 v224, v212 offset:28
    ds_write_b32 v224, v213 offset:60
    ds_write_b32 v224, v214 offset:92
    ds_write_b32 v224, v215 offset:124
    s_mov_b64 exec, s[30:31]
    v_lshlrev_b32 v225, 5, v2
    v_lshlrev_b32 v226, 3, v1
    v_add_u32 v225, v225, v226
    v_add_u32 v225, 0x4000, v225
    v_mov_b32 v226, v10
    v_mov_b32 v227, v13
    v_cmp_gt_u32 vcc, 4, v1
    s_and_saveexec_b64 s[30:31], vcc
    ds_write_b64 v225, v[226:227]
    s_mov_b64 exec, s[30:31]
    s_waitcnt lgkmcnt(0)
    s_barrier
    v_lshrrev_b32 v224, 7, v0
    v_lshlrev_b32 v225, 3, v224
    v_add_u32 v225, 0x4000, v225
    ds_read_b64 v[32:33], v225 offset:0
    ds_read_b64 v[34:35], v225 offset:32
    ds_read_b64 v[36:37], v225 offset:64
    ds_read_b64 v[38:39], v225 offset:96
    ds_read_b64 v[40:41], v225 offset:128
    ds_read_b64 v[42:43], v225 offset:160
    ds_read_b64 v[44:45], v225 offset:192
    ds_read_b64 v[46:47], v225 offset:224
    v_lshlrev_b32 v226, 9, v224
    v_and_b32 v227, 127, v0
    v_lshlrev_b32 v227, 2, v227
    v_add_u32 v226, v226, v227
    ds_read_b32 v48, v226 offset:0
    ds_read_b32 v49, v226 offset:2048
    ds_read_b32 v50, v226 offset:4096
    ds_read_b32 v51, v226 offset:6144
    ds_read_b32 v52, v226 offset:8192
    ds_read_b32 v53, v226 offset:10240
    ds_read_b32 v54, v226 offset:12288
    ds_read_b32 v55, v226 offset:14336
    s_waitcnt lgkmcnt(0)
    v_max3_f32 v56, v32, v34, v36
    v_max3_f32 v56, v56, v38, v40
    v_max3_f32 v56, v56, v42, v44
    v_max_f32 v56, v56, v46
    v_mul_f32 v57, s24, v56
    v_sub_f32 v57, 0, v57
    v_fma_f32 v60, v32, s24, v57
    v_fma_f32 v61, v34, s24, v57
    v_fma_f32 v62, v36, s24, v57
    v_fma_f32 v63, v38, s24, v57
    v_fma_f32 v64, v40, s24, v57
    v_fma_f32 v65, v42, s24, v57
    v_fma_f32 v66, v44, s24, v57
    v_fma_f32 v67, v46, s24, v57
    v_exp_f32 v60, v60
    v_exp_f32 v61, v61
    v_exp_f32 v62, v62
    v_exp_f32 v63, v63
    v_exp_f32 v64, v64
    v_exp_f32 v65, v65
    v_exp_f32 v66, v66
    v_exp_f32 v67, v67
    s_nop 1
    v_mul_f32 v58, v60, v33
    v_mul_f32 v59, v60, v48
    v_fma_f32 v58, v61, v35, v58
    v_fma_f32 v59, v61, v49, v59
    v_fma_f32 v58, v62, v37, v58
    v_fma_f32 v59, v62, v50, v59
    v_fma_f32 v58, v63, v39, v58
    v_fma_f32 v59, v63, v51, v59
    v_fma_f32 v58, v64, v41, v58
    v_fma_f32 v59, v64, v52, v59
    v_fma_f32 v58, v65, v43, v58
    v_fma_f32 v59, v65, v53, v59
    v_fma_f32 v58, v66, v45, v58
    v_fma_f32 v59, v66, v54, v59
    v_fma_f32 v58, v67, v47, v58
    v_fma_f32 v59, v67, v55, v59
    s_lshl_b32 s7, s3, 2
    s_add_u32 s7, s7, s4
    s_lshl_b32 s7, s7, 5
    s_lshl_b32 s25, s5, 2
    s_add_u32 s7, s7, s25
    s_lshl_b32 s7, s7, 2
    s_add_u32 s7, s7, s6
    s_lshl_b32 s25, s7, 9
    s_add_u32 s25, s25, 0x10000
    v_lshlrev_b32 v226, 11, v224
    v_add_u32 v226, v226, v227
    v_add_u32 v226, s25, v226
    buffer_store_dword v59, v226, s[16:19], 0 offen
    s_lshl_b32 s25, s7, 3
    s_add_u32 s25, s25, 0x90000
    v_lshlrev_b32 v226, 5, v224
    v_add_u32 v226, s25, v226
    v_mov_b32 v68, v56
    v_mov_b32 v69, v58
    v_and_b32 v227, 127, v0
    v_cmp_eq_u32 vcc, 0, v227
    s_and_saveexec_b64 s[30:31], vcc
    buffer_store_dwordx2 v[68:69], v226, s[16:19], 0 offen
    s_mov_b64 exec, s[30:31]
    s_waitcnt vmcnt(0)
L_a_done:
    s_endpgm
.globl oproj_kernel
.p2align 8
.type oproj_kernel,@function
oproj_kernel:
    s_cmp_ge_u32 s2, 256
    s_cbranch_scc1 L_o_done
    s_lshr_b32 s3, s2, 7
    s_mul_i32 s4, s3, 40
    s_add_u32 s5, s4, 32
    s_load_dwordx2 s[12:13], s[0:1], s5
    s_load_dwordx2 s[16:17], s[0:1], 96
    s_load_dwordx2 s[8:9], s[0:1], 80
    s_load_dwordx2 s[32:33], s[0:1], 88
    s_lshr_b32 s4, s2, 5
    s_and_b32 s4, s4, 3
    s_and_b32 s5, s2, 31
    v_and_b32 v1, 63, v0
    v_lshrrev_b32 v2, 6, v0
    v_and_b32 v3, 15, v1
    v_lshrrev_b32 v4, 4, v1
    v_lshlrev_b32 v5, 15, v2
    v_lshlrev_b32 v6, 13, v4
    v_add_u32 v5, v5, v6
    v_lshlrev_b32 v6, 4, v3
    v_add_u32 v5, v5, v6
    s_lshl_b32 s7, s5, 17
    s_lshl_b32 s20, s4, 8
    s_add_u32 s7, s7, s20
    v_add_u32 v5, s7, v5
    s_mov_b32 s20, 0
    s_mov_b32 s21, 0x1000
    v_and_b32 v6, 3, v1
    v_lshlrev_b32 v7, 10, v6
    s_lshl_b32 s7, s3, 12
    s_lshl_b32 s22, s5, 5
    s_add_u32 s7, s7, s22
    s_add_u32 s7, s7, 0x90000
    v_add_u32 v7, s7, v7
    v_lshlrev_b32 v8, 16, v6
    v_lshlrev_b32 v9, 7, v2
    v_add_u32 v8, v8, v9
    v_lshlrev_b32 v9, 5, v4
    v_add_u32 v8, v8, v9
    s_lshl_b32 s7, s3, 18
    s_lshl_b32 s22, s5, 11
    s_add_u32 s7, s7, s22
    s_add_u32 s7, s7, 0x10000
    v_add_u32 v8, s7, v8
    s_mov_b32 s28, 0x05040100
    s_mov_b32 s29, 0x07060302
    s_mov_b32 s24, 0x3e0293ee
    s_waitcnt lgkmcnt(0)
    s_mov_b32 s14, 0x400000
    s_mov_b32 s15, 0x00020000
    s_mov_b32 s18, 0x11002000
    s_mov_b32 s19, 0x00020000
    s_mov_b32 s10, 0x2000
    s_mov_b32 s11, 0x00020000
    s_mov_b32 s34, 0x100
    s_mov_b32 s35, 0x00020000
    buffer_load_dwordx4 v[12:15], v5, s[12:15], s20 offen offset:0 nt
    buffer_load_dwordx4 v[16:19], v5, s[12:15], s20 offen offset:1024 nt
    buffer_load_dwordx4 v[20:23], v5, s[12:15], s20 offen offset:2048 nt
    buffer_load_dwordx4 v[24:27], v5, s[12:15], s20 offen offset:3072 nt
    buffer_load_dwordx4 v[28:31], v5, s[12:15], s21 offen offset:0 nt
    buffer_load_dwordx4 v[32:35], v5, s[12:15], s21 offen offset:1024 nt
    buffer_load_dwordx4 v[36:39], v5, s[12:15], s21 offen offset:2048 nt
    buffer_load_dwordx4 v[40:43], v5, s[12:15], s21 offen offset:3072 nt
    buffer_load_dwordx4 v[44:47], v7, s[16:19], 0 offen
    buffer_load_dwordx4 v[48:51], v7, s[16:19], 0 offen offset:16
    buffer_load_dwordx4 v[52:55], v8, s[16:19], 0 offen offset:0
    buffer_load_dwordx4 v[56:59], v8, s[16:19], 0 offen offset:16
    buffer_load_dwordx4 v[60:63], v8, s[16:19], 0 offen offset:512
    buffer_load_dwordx4 v[64:67], v8, s[16:19], 0 offen offset:528
    buffer_load_dwordx4 v[68:71], v8, s[16:19], 0 offen offset:1024
    buffer_load_dwordx4 v[72:75], v8, s[16:19], 0 offen offset:1040
    buffer_load_dwordx4 v[76:79], v8, s[16:19], 0 offen offset:1536
    buffer_load_dwordx4 v[80:83], v8, s[16:19], 0 offen offset:1552
    s_waitcnt vmcnt(0)
    v_max3_f32 v84, v44, v46, v48
    v_max_f32 v84, v84, v50
    v_mul_f32 v85, s24, v84
    v_sub_f32 v85, 0, v85
    v_fma_f32 v86, v44, s24, v85
    v_fma_f32 v87, v46, s24, v85
    v_fma_f32 v88, v48, s24, v85
    v_fma_f32 v89, v50, s24, v85
    v_exp_f32 v86, v86
    v_exp_f32 v87, v87
    v_exp_f32 v88, v88
    v_exp_f32 v89, v89
    s_nop 1
    v_mul_f32 v90, v86, v45
    v_fma_f32 v90, v87, v47, v90
    v_fma_f32 v90, v88, v49, v90
    v_fma_f32 v90, v89, v51, v90
    v_rcp_f32 v90, v90
    s_nop 1
    v_mul_f32 v86, v86, v90
    v_mul_f32 v87, v87, v90
    v_mul_f32 v88, v88, v90
    v_mul_f32 v89, v89, v90
    v_mul_f32 v92, v86, v52
    v_fma_f32 v92, v87, v60, v92
    v_fma_f32 v92, v88, v68, v92
    v_fma_f32 v92, v89, v76, v92
    v_mul_f32 v93, v86, v53
    v_fma_f32 v93, v87, v61, v93
    v_fma_f32 v93, v88, v69, v93
    v_fma_f32 v93, v89, v77, v93
    v_mul_f32 v94, v86, v54
    v_fma_f32 v94, v87, v62, v94
    v_fma_f32 v94, v88, v70, v94
    v_fma_f32 v94, v89, v78, v94
    v_mul_f32 v95, v86, v55
    v_fma_f32 v95, v87, v63, v95
    v_fma_f32 v95, v88, v71, v95
    v_fma_f32 v95, v89, v79, v95
    v_mul_f32 v96, v86, v56
    v_fma_f32 v96, v87, v64, v96
    v_fma_f32 v96, v88, v72, v96
    v_fma_f32 v96, v89, v80, v96
    v_mul_f32 v97, v86, v57
    v_fma_f32 v97, v87, v65, v97
    v_fma_f32 v97, v88, v73, v97
    v_fma_f32 v97, v89, v81, v97
    v_mul_f32 v98, v86, v58
    v_fma_f32 v98, v87, v66, v98
    v_fma_f32 v98, v88, v74, v98
    v_fma_f32 v98, v89, v82, v98
    v_mul_f32 v99, v86, v59
    v_fma_f32 v99, v87, v67, v99
    v_fma_f32 v99, v88, v75, v99
    v_fma_f32 v99, v89, v83, v99
    v_cvt_pk_bf16_f32 v100, v92, v93
    v_cvt_pk_bf16_f32 v101, v94, v95
    v_cvt_pk_bf16_f32 v102, v96, v97
    v_cvt_pk_bf16_f32 v103, v98, v99
    v_perm_b32 v104, v16, v12, s28
    v_perm_b32 v105, v24, v20, s28
    v_perm_b32 v106, v32, v28, s28
    v_perm_b32 v107, v40, v36, s28
    s_nop 1
    v_mfma_f32_16x16x32_bf16 v[112:115], v[100:103], v[104:107], 0
    v_perm_b32 v108, v16, v12, s29
    v_perm_b32 v109, v24, v20, s29
    v_perm_b32 v110, v32, v28, s29
    v_perm_b32 v111, v40, v36, s29
    s_nop 1
    v_mfma_f32_16x16x32_bf16 v[116:119], v[100:103], v[108:111], 0
    v_perm_b32 v104, v17, v13, s28
    v_perm_b32 v105, v25, v21, s28
    v_perm_b32 v106, v33, v29, s28
    v_perm_b32 v107, v41, v37, s28
    s_nop 1
    v_mfma_f32_16x16x32_bf16 v[120:123], v[100:103], v[104:107], 0
    v_perm_b32 v108, v17, v13, s29
    v_perm_b32 v109, v25, v21, s29
    v_perm_b32 v110, v33, v29, s29
    v_perm_b32 v111, v41, v37, s29
    s_nop 1
    v_mfma_f32_16x16x32_bf16 v[124:127], v[100:103], v[108:111], 0
    v_perm_b32 v104, v18, v14, s28
    v_perm_b32 v105, v26, v22, s28
    v_perm_b32 v106, v34, v30, s28
    v_perm_b32 v107, v42, v38, s28
    s_nop 1
    v_mfma_f32_16x16x32_bf16 v[128:131], v[100:103], v[104:107], 0
    v_perm_b32 v108, v18, v14, s29
    v_perm_b32 v109, v26, v22, s29
    v_perm_b32 v110, v34, v30, s29
    v_perm_b32 v111, v42, v38, s29
    s_nop 1
    v_mfma_f32_16x16x32_bf16 v[132:135], v[100:103], v[108:111], 0
    v_perm_b32 v104, v19, v15, s28
    v_perm_b32 v105, v27, v23, s28
    v_perm_b32 v106, v35, v31, s28
    v_perm_b32 v107, v43, v39, s28
    s_nop 1
    v_mfma_f32_16x16x32_bf16 v[136:139], v[100:103], v[104:107], 0
    v_perm_b32 v108, v19, v15, s29
    v_perm_b32 v109, v27, v23, s29
    v_perm_b32 v110, v35, v31, s29
    v_perm_b32 v111, v43, v39, s29
    s_nop 1
    v_mfma_f32_16x16x32_bf16 v[140:143], v[100:103], v[108:111], 0
    s_nop 7
    s_nop 3
    v_lshlrev_b32 v6, 11, v2
    v_lshlrev_b32 v7, 5, v3
    v_add_u32 v6, v6, v7
    v_cmp_gt_u32 vcc, 16, v1
    s_and_saveexec_b64 s[30:31], vcc
    ds_write_b32 v6, v112 offset:0
    ds_write_b32 v6, v113 offset:512
    ds_write_b32 v6, v114 offset:1024
    ds_write_b32 v6, v115 offset:1536
    ds_write_b32 v6, v116 offset:4
    ds_write_b32 v6, v117 offset:516
    ds_write_b32 v6, v118 offset:1028
    ds_write_b32 v6, v119 offset:1540
    ds_write_b32 v6, v120 offset:8
    ds_write_b32 v6, v121 offset:520
    ds_write_b32 v6, v122 offset:1032
    ds_write_b32 v6, v123 offset:1544
    ds_write_b32 v6, v124 offset:12
    ds_write_b32 v6, v125 offset:524
    ds_write_b32 v6, v126 offset:1036
    ds_write_b32 v6, v127 offset:1548
    ds_write_b32 v6, v128 offset:16
    ds_write_b32 v6, v129 offset:528
    ds_write_b32 v6, v130 offset:1040
    ds_write_b32 v6, v131 offset:1552
    ds_write_b32 v6, v132 offset:20
    ds_write_b32 v6, v133 offset:532
    ds_write_b32 v6, v134 offset:1044
    ds_write_b32 v6, v135 offset:1556
    ds_write_b32 v6, v136 offset:24
    ds_write_b32 v6, v137 offset:536
    ds_write_b32 v6, v138 offset:1048
    ds_write_b32 v6, v139 offset:1560
    ds_write_b32 v6, v140 offset:28
    ds_write_b32 v6, v141 offset:540
    ds_write_b32 v6, v142 offset:1052
    ds_write_b32 v6, v143 offset:1564
    s_mov_b64 exec, s[30:31]
    s_waitcnt lgkmcnt(0)
    s_barrier
    v_lshlrev_b32 v6, 3, v0
    ds_read_b64 v[12:13], v6 offset:0
    ds_read_b64 v[14:15], v6 offset:2048
    ds_read_b64 v[16:17], v6 offset:4096
    ds_read_b64 v[18:19], v6 offset:6144
    s_waitcnt lgkmcnt(0)
    v_add_f32 v12, v12, v14
    v_add_f32 v13, v13, v15
    v_add_f32 v12, v12, v16
    v_add_f32 v13, v13, v17
    v_add_f32 v12, v12, v18
    v_add_f32 v13, v13, v19
    s_lshl_b32 s7, s3, 2
    s_add_u32 s7, s7, s4
    s_lshl_b32 s22, s7, 16
    s_add_u32 s22, s22, 0xa0000
    s_lshl_b32 s23, s5, 11
    s_add_u32 s23, s23, s22
    v_add_u32 v7, s23, v6
    buffer_store_dwordx2 v[12:13], v7, s[16:19], 0 offen sc0 sc1
    s_waitcnt vmcnt(0)
    s_barrier
    s_mov_b32 s37, 0x800
    s_mov_b32 s38, 0x1000
    s_mov_b32 s39, 0x1800
    s_mov_b32 s40, 0x2000
    s_mov_b32 s41, 0x2800
    s_mov_b32 s42, 0x3000
    s_mov_b32 s43, 0x3800
    s_mov_b32 s44, 0x4000
    s_mov_b32 s45, 0x4800
    s_mov_b32 s46, 0x5000
    s_mov_b32 s47, 0x5800
    s_mov_b32 s48, 0x6000
    s_mov_b32 s49, 0x6800
    s_mov_b32 s50, 0x7000
    s_mov_b32 s51, 0x7800
    s_mov_b32 s52, 0x8000
    s_mov_b32 s53, 0x8800
    s_mov_b32 s54, 0x9000
    s_mov_b32 s55, 0x9800
    s_mov_b32 s56, 0xa000
    s_mov_b32 s57, 0xa800
    s_mov_b32 s58, 0xb000
    s_mov_b32 s59, 0xb800
    s_mov_b32 s60, 0xc000
    s_mov_b32 s61, 0xc800
    s_mov_b32 s62, 0xd000
    s_mov_b32 s63, 0xd800
    s_mov_b32 s64, 0xe000
    s_mov_b32 s65, 0xe800
    s_mov_b32 s66, 0xf000
    s_mov_b32 s67, 0xf800
    v_cmp_eq_u32 vcc, 0, v0
    s_and_saveexec_b64 s[30:31], vcc
    v_mov_b32 v14, 1
    s_lshl_b32 s25, s7, 4
    v_mov_b32 v15, s25
    buffer_atomic_add v14, v15, s[32:35], 0 offen sc0 sc1
    s_waitcnt vmcnt(0)
    v_mov_b32 v16, 0x2000
    ds_write_b32 v16, v14
    s_mov_b64 exec, s[30:31]
    s_waitcnt lgkmcnt(0)
    s_barrier
    v_mov_b32 v16, 0x2000
    ds_read_b32 v14, v16
    s_waitcnt lgkmcnt(0)
    v_readfirstlane_b32 s26, v14
    s_cmp_lg_u32 s26, 31
    s_cbranch_scc1 L_o_done
    v_add_u32 v7, s22, v6
    buffer_load_dwordx2 v[20:21], v7, s[16:19], 0 offen offset:0 sc0 sc1
    buffer_load_dwordx2 v[22:23], v7, s[16:19], s37 offen sc0 sc1
    buffer_load_dwordx2 v[24:25], v7, s[16:19], s38 offen sc0 sc1
    buffer_load_dwordx2 v[26:27], v7, s[16:19], s39 offen sc0 sc1
    buffer_load_dwordx2 v[28:29], v7, s[16:19], s40 offen sc0 sc1
    buffer_load_dwordx2 v[30:31], v7, s[16:19], s41 offen sc0 sc1
    buffer_load_dwordx2 v[32:33], v7, s[16:19], s42 offen sc0 sc1
    buffer_load_dwordx2 v[34:35], v7, s[16:19], s43 offen sc0 sc1
    buffer_load_dwordx2 v[36:37], v7, s[16:19], s44 offen sc0 sc1
    buffer_load_dwordx2 v[38:39], v7, s[16:19], s45 offen sc0 sc1
    buffer_load_dwordx2 v[40:41], v7, s[16:19], s46 offen sc0 sc1
    buffer_load_dwordx2 v[42:43], v7, s[16:19], s47 offen sc0 sc1
    buffer_load_dwordx2 v[44:45], v7, s[16:19], s48 offen sc0 sc1
    buffer_load_dwordx2 v[46:47], v7, s[16:19], s49 offen sc0 sc1
    buffer_load_dwordx2 v[48:49], v7, s[16:19], s50 offen sc0 sc1
    buffer_load_dwordx2 v[50:51], v7, s[16:19], s51 offen sc0 sc1
    buffer_load_dwordx2 v[52:53], v7, s[16:19], s52 offen sc0 sc1
    buffer_load_dwordx2 v[54:55], v7, s[16:19], s53 offen sc0 sc1
    buffer_load_dwordx2 v[56:57], v7, s[16:19], s54 offen sc0 sc1
    buffer_load_dwordx2 v[58:59], v7, s[16:19], s55 offen sc0 sc1
    buffer_load_dwordx2 v[60:61], v7, s[16:19], s56 offen sc0 sc1
    buffer_load_dwordx2 v[62:63], v7, s[16:19], s57 offen sc0 sc1
    buffer_load_dwordx2 v[64:65], v7, s[16:19], s58 offen sc0 sc1
    buffer_load_dwordx2 v[66:67], v7, s[16:19], s59 offen sc0 sc1
    buffer_load_dwordx2 v[68:69], v7, s[16:19], s60 offen sc0 sc1
    buffer_load_dwordx2 v[70:71], v7, s[16:19], s61 offen sc0 sc1
    buffer_load_dwordx2 v[72:73], v7, s[16:19], s62 offen sc0 sc1
    buffer_load_dwordx2 v[74:75], v7, s[16:19], s63 offen sc0 sc1
    buffer_load_dwordx2 v[76:77], v7, s[16:19], s64 offen sc0 sc1
    buffer_load_dwordx2 v[78:79], v7, s[16:19], s65 offen sc0 sc1
    buffer_load_dwordx2 v[80:81], v7, s[16:19], s66 offen sc0 sc1
    buffer_load_dwordx2 v[82:83], v7, s[16:19], s67 offen sc0 sc1
    s_waitcnt vmcnt(0)
    v_add_f32 v20, v20, v22
    v_add_f32 v21, v21, v23
    v_add_f32 v20, v20, v24
    v_add_f32 v21, v21, v25
    v_add_f32 v20, v20, v26
    v_add_f32 v21, v21, v27
    v_add_f32 v20, v20, v28
    v_add_f32 v21, v21, v29
    v_add_f32 v20, v20, v30
    v_add_f32 v21, v21, v31
    v_add_f32 v20, v20, v32
    v_add_f32 v21, v21, v33
    v_add_f32 v20, v20, v34
    v_add_f32 v21, v21, v35
    v_add_f32 v20, v20, v36
    v_add_f32 v21, v21, v37
    v_add_f32 v20, v20, v38
    v_add_f32 v21, v21, v39
    v_add_f32 v20, v20, v40
    v_add_f32 v21, v21, v41
    v_add_f32 v20, v20, v42
    v_add_f32 v21, v21, v43
    v_add_f32 v20, v20, v44
    v_add_f32 v21, v21, v45
    v_add_f32 v20, v20, v46
    v_add_f32 v21, v21, v47
    v_add_f32 v20, v20, v48
    v_add_f32 v21, v21, v49
    v_add_f32 v20, v20, v50
    v_add_f32 v21, v21, v51
    v_add_f32 v20, v20, v52
    v_add_f32 v21, v21, v53
    v_add_f32 v20, v20, v54
    v_add_f32 v21, v21, v55
    v_add_f32 v20, v20, v56
    v_add_f32 v21, v21, v57
    v_add_f32 v20, v20, v58
    v_add_f32 v21, v21, v59
    v_add_f32 v20, v20, v60
    v_add_f32 v21, v21, v61
    v_add_f32 v20, v20, v62
    v_add_f32 v21, v21, v63
    v_add_f32 v20, v20, v64
    v_add_f32 v21, v21, v65
    v_add_f32 v20, v20, v66
    v_add_f32 v21, v21, v67
    v_add_f32 v20, v20, v68
    v_add_f32 v21, v21, v69
    v_add_f32 v20, v20, v70
    v_add_f32 v21, v21, v71
    v_add_f32 v20, v20, v72
    v_add_f32 v21, v21, v73
    v_add_f32 v20, v20, v74
    v_add_f32 v21, v21, v75
    v_add_f32 v20, v20, v76
    v_add_f32 v21, v21, v77
    v_add_f32 v20, v20, v78
    v_add_f32 v21, v21, v79
    v_add_f32 v20, v20, v80
    v_add_f32 v21, v21, v81
    v_add_f32 v20, v20, v82
    v_add_f32 v21, v21, v83
    v_cvt_pk_bf16_f32 v20, v20, v21
    v_lshrrev_b32 v8, 6, v0
    v_lshlrev_b32 v8, 11, v8
    v_and_b32 v9, 63, v0
    v_lshlrev_b32 v9, 2, v9
    v_add_u32 v8, v8, v9
    s_lshl_b32 s25, s3, 10
    s_lshl_b32 s26, s4, 8
    s_add_u32 s25, s25, s26
    v_add_u32 v8, s25, v8
    buffer_store_dword v20, v8, s[8:11], 0 offen
    s_waitcnt vmcnt(0)
L_o_done:
    s_endpgm
.section .rodata,"a"
.p2align 6
.amdhsa_kernel qproj_kernel
  .amdhsa_next_free_vgpr 84
  .amdhsa_next_free_sgpr 40
  .amdhsa_accum_offset 84
  .amdhsa_group_segment_fixed_size 0
  .amdhsa_kernarg_size 104
  .amdhsa_user_sgpr_count 2
  .amdhsa_user_sgpr_kernarg_segment_ptr 1
  .amdhsa_system_sgpr_workgroup_id_x 1
.end_amdhsa_kernel
.section .rodata,"a"
.p2align 6
.amdhsa_kernel concat_heads__sliding_block_cached__sliding_block_cached__decode_kernel
  .amdhsa_next_free_vgpr 228
  .amdhsa_next_free_sgpr 40
  .amdhsa_accum_offset 228
  .amdhsa_group_segment_fixed_size 0
  .amdhsa_kernarg_size 104
  .amdhsa_user_sgpr_count 2
  .amdhsa_user_sgpr_kernarg_segment_ptr 1
  .amdhsa_system_sgpr_workgroup_id_x 1
.end_amdhsa_kernel
.section .rodata,"a"
.p2align 6
.amdhsa_kernel oproj_kernel
  .amdhsa_next_free_vgpr 144
  .amdhsa_next_free_sgpr 72
  .amdhsa_accum_offset 144
  .amdhsa_group_segment_fixed_size 0
  .amdhsa_kernarg_size 104
  .amdhsa_user_sgpr_count 2
  .amdhsa_user_sgpr_kernarg_segment_ptr 1
  .amdhsa_system_sgpr_workgroup_id_x 1
.end_amdhsa_kernel
```
